```python
import torch

def _softmax(x, axis=-1):
    return torch.softmax(x, dim=axis)

def _gelu(x):
    return torch.nn.functional.gelu(x, approximate='tanh')

def _silu(x):
    return torch.nn.functional.silu(x)

def _sigmoid(x):
    return torch.sigmoid(x)

def _layernorm(x, axis=-1, eps=1e-05):
    m = x.mean(dim=axis, keepdim=True)
    v = x.var(dim=axis, keepdim=True, unbiased=False)
    return (x - m) / torch.sqrt(v + eps)

def _scatter_add(tgt, idx, src, axis=0):
    return tgt.clone().index_add_(axis, idx, src)

def _segment_sum(src, seg, n):
    out = torch.zeros((n,) + src.shape[1:], dtype=src.dtype)
    return out.index_add_(0, seg, src)

def _pad(x, pw):
    flat = tuple((v for pair in reversed(pw) for v in pair))
    return torch.nn.functional.pad(x, flat)
kernel_name = 'standalone__tensor_product_equiv_equiformer__graph'

def setup_inputs():

    _w = lambda a: (lambda t: t.to(torch.bfloat16) if t.is_floating_point() else t)(torch.as_tensor(a))
    N, deg, C, De = (10000, 64, 64, max(4, 1))
    E = N * deg
    src = (lambda lo, hi, *s: torch.randint(lo, hi, s))(0, N, E).to(torch.int64)
    dst = (lambda lo, hi, *s: torch.randint(lo, hi, s))(0, N, E).to(torch.int64)
    rvec = (lambda *s: torch.randn(*s, dtype=torch.bfloat16) * 0.05)(E, 3).to(float)
    rn = (torch.linalg.norm(rvec, dim=-1, keepdim=True) + 1e-06).to(float)
    rhat = (rvec / rn).to(float)
    eps = torch.zeros((3, 3, 3), dtype=float)
    eps[0, 1, 2] = eps[1, 2, 0] = eps[2, 0, 1] = 1.0
    eps[0, 2, 1] = eps[2, 1, 0] = eps[1, 0, 2] = -1.0
    return {'x': _w((lambda *s: torch.randn(*s, dtype=torch.bfloat16) * 0.4)(N, 4 * C).to(float)), 'rhat': _w(rhat), 'e_attr': _w((lambda *s: torch.randn(*s, dtype=torch.bfloat16) * 0.4)(E, De).to(float)), 'src': _w(src), 'dst': _w(dst), 'w_rad': _w((lambda *s: torch.randn(*s, dtype=torch.bfloat16) * 0.4)(De, 5 * C).to(float)), 'w_si0': _w((lambda *s: torch.randn(*s, dtype=torch.bfloat16) * 0.4)(2 * C, C).to(float)), 'w_si1': _w((lambda *s: torch.randn(*s, dtype=torch.bfloat16) * 0.05)(3 * C, C).to(float)), 'cg_eps': _w(eps)}

def reference(x, rhat, e_attr, src, dst, w_rad, w_si0, w_si1, cg_eps):
    N = x.shape[0]
    C = w_si0.shape[1]
    E = rhat.shape[0]
    x0 = x[:, :C].clone()
    x1 = x[:, C:].reshape(N, 3, C)
    R = (e_attr @ w_rad).reshape(E, 5, C)
    f0 = x0[src]
    f1 = x1[src]
    Y1 = rhat
    p00_0 = f0 * R[:, 0, :]
    p11_0 = torch.einsum('ejc,ej->ec', f1, Y1) * R[:, 1, :]
    p01_1 = torch.einsum('ec,ej->ejc', f0, Y1) * R[:, 2, :][:, None, :]
    p10_1 = f1 * R[:, 3, :][:, None, :]
    p11_1 = torch.einsum('ijk,ekc,ej->eic', cg_eps, f1, Y1) * R[:, 4, :][:, None, :]
    m0 = torch.concatenate([p00_0, p11_0], axis=-1) @ w_si0
    m1 = torch.einsum('ejp,pc->ejc', torch.concatenate([p01_1, p10_1, p11_1], axis=-1), w_si1)
    agg0 = _segment_sum(m0, dst, N)
    agg1 = _segment_sum(m1.reshape(E, 3 * C), dst, N).reshape(N, 3, C)
    gate = _sigmoid(agg0)
    out1 = agg1 * gate[:, None, :]
    return torch.concatenate([agg0, out1.reshape(N, 3 * C)], axis=-1)
```

```asm
; @launch grid=(256,1,1) block=(768,1,1) lds=163840
.amdgcn_target "amdgcn-amd-amdhsa--gfx950"
.text
.p2align 8
.globl standalone__tensor_product_equiv_equiformer__graph_kernel
.type standalone__tensor_product_equiv_equiformer__graph_kernel,@function
standalone__tensor_product_equiv_equiformer__graph_kernel:
    s_cmp_ge_u32 s2, 256
    s_cbranch_scc1 K2_END
    s_load_dwordx4 s[28:31], s[0:1], 24
    s_load_dwordx4 s[24:27], s[0:1], 8
    s_load_dwordx2 s[8:9], s[0:1], 88
    s_load_dwordx2 s[4:5], s[0:1], 0
    s_load_dwordx2 s[12:13], s[0:1], 72
    s_load_dwordx2 s[16:17], s[0:1], 40
    v_lshrrev_b32 v1, 6, v0
    s_nop 0
    v_readfirstlane_b32 s18, v1
    s_movk_i32 s6, 10000
    s_mov_b32 s7, 0x20000
    s_mov_b32 s10, 0x2000000
    s_mov_b32 s11, 0x20000
    s_mov_b32 s14, 0
    s_mov_b32 s15, 0x20000
    s_and_b32 s21, s2, 7
    s_lshl_b32 s21, s21, 5
    s_lshr_b32 s44, s2, 3
    s_add_u32 s21, s21, s44
    v_and_b32 v31, 63, v0
    v_lshlrev_b32 v5, 2, v0
    v_mov_b32 v6, 0
    ds_write_b32 v5, v6
    v_lshlrev_b32 v43, 4, v31
    s_cmp_eq_u32 s18, 10
    s_cbranch_scc1 P_W10
    s_cmp_eq_u32 s18, 11
    s_cbranch_scc1 P_W11
    s_cmp_ge_u32 s2, 250
    s_cbranch_scc1 P_EXTRA
    s_mul_i32 s32, s2, 640
    v_add_u32 v1, s32, v0
    v_lshlrev_b32 v2, 4, v1
    v_lshlrev_b32 v3, 5, v1
    v_mul_u32_u24 v4, 24, v1
    s_movk_i32 s33, 625
    v_lshlrev_b32 v40, 4, v0
    s_waitcnt lgkmcnt(0)
    v_mov_b32 v6, 1
    global_load_dwordx4 v[8:11], v2, s[30:31] nt
    s_add_u32 s40, s8, 0xae0000
    s_addc_u32 s41, s9, 0
    s_load_dword s62, s[40:41], 0
    s_barrier
    global_load_dwordx4 v[12:15], v2, s[28:29] nt
    global_load_dwordx4 v[16:19], v3, s[26:27] nt
    global_load_dwordx4 v[20:23], v3, s[26:27] offset:16 nt
    global_load_dwordx4 v[24:27], v4, s[24:25] nt
    global_load_dwordx2 v[28:29], v4, s[24:25] offset:16 nt
    s_waitcnt vmcnt(5)
    v_mul_u32_u24 v32, 429497, v8
    v_lshrrev_b32 v32, 24, v32
    v_mad_u32_u24 v41, v32, s33, 15
    v_lshlrev_b32 v32, 2, v32
    ds_add_rtn_u32 v36, v32, v6
    v_lshrrev_b32 v41, 4, v41
    v_sub_u32 v8, v8, v41
    v_mul_u32_u24 v33, 429497, v9
    v_lshrrev_b32 v33, 24, v33
    v_mad_u32_u24 v41, v33, s33, 15
    v_lshlrev_b32 v33, 2, v33
    ds_add_rtn_u32 v37, v33, v6
    v_lshrrev_b32 v41, 4, v41
    v_sub_u32 v9, v9, v41
    v_mul_u32_u24 v34, 429497, v10
    v_lshrrev_b32 v34, 24, v34
    v_mad_u32_u24 v41, v34, s33, 15
    v_lshlrev_b32 v34, 2, v34
    ds_add_rtn_u32 v38, v34, v6
    v_lshrrev_b32 v41, 4, v41
    v_sub_u32 v10, v10, v41
    v_mul_u32_u24 v35, 429497, v11
    v_lshrrev_b32 v35, 24, v35
    v_mad_u32_u24 v41, v35, s33, 15
    v_lshlrev_b32 v35, 2, v35
    ds_add_rtn_u32 v39, v35, v6
    v_lshrrev_b32 v41, 4, v41
    v_sub_u32 v11, v11, v41
    s_lshl_b32 s35, s18, 10
    s_waitcnt lgkmcnt(0)
    s_barrier
    ds_read_b128 v[44:47], v43
    v_add_u32 v42, s35, v43
    v_add_u32 v32, s35, v32
    v_add_u32 v33, s35, v33
    v_add_u32 v34, s35, v34
    v_add_u32 v35, s35, v35
    s_waitcnt lgkmcnt(0)
    v_add_u32 v49, v44, v45
    v_add_u32 v50, v49, v46
    v_add_u32 v51, v50, v47
    v_mov_b32 v52, v51
    s_nop 1
    v_add_u32_dpp v52, v52, v52 row_shr:1 row_mask:0xf bank_mask:0xf
    s_nop 1
    v_add_u32_dpp v52, v52, v52 row_shr:2 row_mask:0xf bank_mask:0xf
    s_nop 1
    v_add_u32_dpp v52, v52, v52 row_shr:4 row_mask:0xf bank_mask:0xf
    s_nop 1
    v_add_u32_dpp v52, v52, v52 row_shr:8 row_mask:0xf bank_mask:0xf
    s_nop 1
    v_add_u32_dpp v52, v52, v52 row_bcast:15 row_mask:0xa bank_mask:0xf
    s_nop 1
    v_add_u32_dpp v52, v52, v52 row_bcast:31 row_mask:0xc bank_mask:0xf
    v_sub_u32 v52, v52, v51
    v_add_u32 v53, v52, v44
    v_add_u32 v54, v52, v49
    v_add_u32 v55, v52, v50
    ds_write_b128 v42, v[52:55] offset:1024
    ds_read_b32 v32, v32 offset:1024
    ds_read_b32 v33, v33 offset:1024
    ds_read_b32 v34, v34 offset:1024
    ds_read_b32 v35, v35 offset:1024
    s_waitcnt lgkmcnt(0)
    v_add_u32 v32, v32, v36
    ds_write_b8 v32, v8 offset:53248
    v_lshlrev_b32 v36, 4, v32
    v_add_u32 v33, v33, v37
    ds_write_b8 v33, v9 offset:53248
    v_lshlrev_b32 v37, 4, v33
    v_add_u32 v34, v34, v38
    ds_write_b8 v34, v10 offset:53248
    v_lshlrev_b32 v38, 4, v34
    v_add_u32 v35, v35, v39
    ds_write_b8 v35, v11 offset:53248
    v_lshlrev_b32 v39, 4, v35
    s_waitcnt lgkmcnt(0)
    s_barrier
    s_mov_b32 s34, 0x05040100
    s_mov_b32 s35, 0x07060100
    s_waitcnt vmcnt(0)
    v_mov_b32 v44, v16
    v_mov_b32 v45, v17
    v_perm_b32 v46, v24, v12, s34
    v_alignbit_b32 v47, v25, v24, 16
    ds_write_b128 v36, v[44:47] offset:12288
    v_mov_b32 v48, v18
    v_mov_b32 v49, v19
    v_perm_b32 v50, v25, v13, s35
    v_mov_b32 v51, v26
    ds_write_b128 v37, v[48:51] offset:12288
    v_mov_b32 v16, v20
    v_mov_b32 v17, v21
    v_perm_b32 v18, v27, v14, s34
    v_alignbit_b32 v19, v28, v27, 16
    ds_write_b128 v38, v[16:19] offset:12288
    v_perm_b32 v24, v28, v15, s35
    v_mov_b32 v25, v29
    ds_write_b128 v39, v[22:25] offset:12288
    v_mov_b32 v7, 156416
    s_mov_b64 exec, 1
    ds_add_u32 v7, v6 offset:4
    s_mov_b64 exec, -1
P_SPIN:
    s_sleep 1
    ds_read_b32 v61, v7 offset:4
    s_waitcnt lgkmcnt(0)
    v_readfirstlane_b32 s32, v61
    s_cmp_lt_u32 s32, 10
    s_cbranch_scc1 P_SPIN
    ds_read_b128 v[64:67], v40 offset:12288
    ds_read_b128 v[68:71], v40 offset:22528
    ds_read_b128 v[72:75], v40 offset:32768
    ds_read_b128 v[76:79], v40 offset:43008
    s_branch P_DONE
P_W10:
    s_lshl_b32 s32, s2, 10
    s_add_u32 s32, s32, 0xa80000
    v_add_u32 v56, s32, v43
    s_mul_i32 s32, s2, 2560
    s_add_u32 s32, s32, 0x9d0000
    v_add_u32 v57, s32, v43
    s_waitcnt lgkmcnt(0)
    s_add_u32 s40, s8, 0xae0000
    s_addc_u32 s41, s9, 0
    s_load_dword s62, s[40:41], 0
    s_barrier
    s_barrier
    ds_read_b128 v[44:47], v43
    s_waitcnt lgkmcnt(0)
    v_add_u32 v49, v44, v45
    v_add_u32 v50, v49, v46
    v_add_u32 v51, v50, v47
    v_mov_b32 v52, v51
    s_nop 1
    v_add_u32_dpp v52, v52, v52 row_shr:1 row_mask:0xf bank_mask:0xf
    s_nop 1
    v_add_u32_dpp v52, v52, v52 row_shr:2 row_mask:0xf bank_mask:0xf
    s_nop 1
    v_add_u32_dpp v52, v52, v52 row_shr:4 row_mask:0xf bank_mask:0xf
    s_nop 1
    v_add_u32_dpp v52, v52, v52 row_shr:8 row_mask:0xf bank_mask:0xf
    s_nop 1
    v_add_u32_dpp v52, v52, v52 row_bcast:15 row_mask:0xa bank_mask:0xf
    s_nop 1
    v_add_u32_dpp v52, v52, v52 row_bcast:31 row_mask:0xc bank_mask:0xf
    v_sub_u32 v52, v52, v51
    v_add_u32 v53, v52, v44
    v_add_u32 v54, v52, v49
    v_add_u32 v55, v52, v50
    v_lshl_or_b32 v52, v44, 16, v52
    v_lshl_or_b32 v53, v45, 16, v53
    v_lshl_or_b32 v54, v46, 16, v54
    v_lshl_or_b32 v55, v47, 16, v55
    global_store_dwordx4 v56, v[52:55], s[8:9] sc1
    s_add_u32 s62, s62, 1
    s_barrier
    s_cmp_ge_u32 s2, 250
    s_cbranch_scc1 P_NOKEYS
    ds_read_b128 v[64:67], v43 offset:53248
    ds_read_b128 v[68:71], v43 offset:54272
    ds_read_b128 v[72:75], v43 offset:55296
    s_waitcnt lgkmcnt(0)
    global_store_dwordx4 v57, v[64:67], s[8:9] sc1
    global_store_dwordx4 v57, v[68:71], s[8:9] offset:1024 sc1
    s_mov_b32 exec_hi, 0
    global_store_dwordx4 v57, v[72:75], s[8:9] offset:2048 sc1
    s_mov_b64 exec, -1
P_NOKEYS:
    s_waitcnt vmcnt(0)
    s_lshl_b32 s32, s2, 2
    s_add_u32 s32, s32, 0xad0000
    v_mov_b32 v60, 0
    v_mov_b32 v61, s62
    s_mov_b64 exec, 1
    buffer_store_dword v61, v60, s[8:11], s32 offen sc1
    s_mov_b64 exec, -1
    s_branch P_DONE2
P_W11:
    v_lshrrev_b32 v2, 3, v31
    v_min_u32 v2, 4, v2
    v_lshlrev_b32 v2, 7, v2
    v_and_b32 v3, 7, v0
    v_lshl_add_u32 v2, v3, 4, v2
    v_cmp_le_u32 vcc, 40, v31
    v_mov_b32 v7, 156416
    ds_write_b32 v7, v6
    ds_write_b32 v7, v6 offset:4
    ds_write_b32 v7, v6 offset:8
    ds_write_b32 v7, v6 offset:12
    v_mov_b32 v4, 0x80008000
    v_cndmask_b32 v4, 0, v4, vcc
    v_lshlrev_b32 v3, 5, v31
    v_add_u32 v3, 149248, v3
    v_mov_b32 v5, 0xffff0000
    s_waitcnt lgkmcnt(0)
    s_add_u32 s40, s8, 0xae0000
    s_addc_u32 s41, s9, 0
    s_load_dword s62, s[40:41], 0
    global_load_dwordx4 v[8:11], v2, s[16:17] offset:0
    global_load_dwordx4 v[12:15], v2, s[16:17] offset:640
    global_load_dwordx4 v[16:19], v2, s[16:17] offset:1280
    global_load_dwordx4 v[20:23], v2, s[16:17] offset:1920
    s_barrier
    s_barrier
    s_waitcnt lgkmcnt(0)
    s_barrier
    s_waitcnt vmcnt(0)
    v_xor_b32 v8, v4, v8
    v_lshlrev_b32 v64, 16, v8
    v_and_b32 v65, v5, v8
    v_xor_b32 v9, v4, v9
    v_lshlrev_b32 v66, 16, v9
    v_and_b32 v67, v5, v9
    v_xor_b32 v10, v4, v10
    v_lshlrev_b32 v68, 16, v10
    v_and_b32 v69, v5, v10
    v_xor_b32 v11, v4, v11
    v_lshlrev_b32 v70, 16, v11
    v_and_b32 v71, v5, v11
    v_xor_b32 v12, v4, v12
    v_lshlrev_b32 v72, 16, v12
    v_and_b32 v73, v5, v12
    v_xor_b32 v13, v4, v13
    v_lshlrev_b32 v74, 16, v13
    v_and_b32 v75, v5, v13
    v_xor_b32 v14, v4, v14
    v_lshlrev_b32 v76, 16, v14
    v_and_b32 v77, v5, v14
    v_xor_b32 v15, v4, v15
    v_lshlrev_b32 v78, 16, v15
    v_and_b32 v79, v5, v15
    v_xor_b32 v16, v4, v16
    v_lshlrev_b32 v80, 16, v16
    v_and_b32 v81, v5, v16
    v_xor_b32 v17, v4, v17
    v_lshlrev_b32 v82, 16, v17
    v_and_b32 v83, v5, v17
    v_xor_b32 v18, v4, v18
    v_lshlrev_b32 v84, 16, v18
    v_and_b32 v85, v5, v18
    v_xor_b32 v19, v4, v19
    v_lshlrev_b32 v86, 16, v19
    v_and_b32 v87, v5, v19
    v_xor_b32 v20, v4, v20
    v_lshlrev_b32 v88, 16, v20
    v_and_b32 v89, v5, v20
    v_xor_b32 v21, v4, v21
    v_lshlrev_b32 v90, 16, v21
    v_and_b32 v91, v5, v21
    v_xor_b32 v22, v4, v22
    v_lshlrev_b32 v92, 16, v22
    v_and_b32 v93, v5, v22
    v_xor_b32 v23, v4, v23
    v_lshlrev_b32 v94, 16, v23
    v_and_b32 v95, v5, v23
    s_mov_b32 exec_hi, 0xffff
    ds_write_b128 v3, v[64:67] offset:0
    ds_write_b128 v3, v[68:71] offset:16
    ds_write_b128 v3, v[72:75] offset:1536
    ds_write_b128 v3, v[76:79] offset:1552
    ds_write_b128 v3, v[80:83] offset:3072
    ds_write_b128 v3, v[84:87] offset:3088
    ds_write_b128 v3, v[88:91] offset:4608
    ds_write_b128 v3, v[92:95] offset:4624
    s_mov_b64 exec, -1
    s_waitcnt lgkmcnt(0)
    s_add_u32 s62, s62, 1
    s_branch P_DONE2
P_EXTRA:
    s_waitcnt lgkmcnt(0)
    s_add_u32 s40, s8, 0xae0000
    s_addc_u32 s41, s9, 0
    s_load_dword s62, s[40:41], 0
    s_barrier
    s_barrier
    s_barrier
P_DONE:
    s_waitcnt lgkmcnt(0)
    s_add_u32 s62, s62, 1
P_DONE2:
    v_and_b32 v94, 63, v0
    s_mov_b32 s63, 1
    s_and_b32 s3, s2, 4
    s_cmp_lg_u32 s3, 0
    s_cselect_b32 s3, 256, 0
    s_or_b32 s5, s5, 0x2000000
    v_lshrrev_b32 v91, 3, v94
    v_and_b32 v89, 7, v0
    s_mov_b32 s50, 0x05040100
    s_mov_b32 s51, 0x07060302
    s_mov_b32 s48, 0x9d0000
    s_mov_b32 s49, 0xffff0000
    s_mov_b32 s19, 0
    s_movk_i32 s43, 3072
    s_movk_i32 s57, 2560
    s_movk_i32 s58, 5120
    s_movk_i32 s59, 7680
    s_mul_i32 s56, s21, 625
    s_add_u32 s54, s56, 640
    s_add_u32 s56, s56, 15
    s_lshr_b32 s56, s56, 4
    s_lshr_b32 s54, s54, 4
    s_sub_u32 s54, s54, s56
    s_lshl_b32 s55, s54, 1
    s_lshr_b32 s60, s18, 2
    s_and_b32 s61, s18, 3
    v_and_b32 v1, 48, v0
    v_bfe_u32 v90, v0, 2, 2
    v_lshlrev_b32 v2, 7, v90
    v_lshl_add_u32 v2, v1, 1, v2
    v_and_b32 v90, 3, v0
    v_lshl_add_u32 v2, v90, 3, v2
    v_lshrrev_b32 v3, 3, v1
    v_lshlrev_b32 v7, 4, v1
    v_mov_b32 v8, 1
    v_mov_b32 v11, 148992
    v_lshlrev_b32 v90, 2, v91
    s_mov_b32 s44, 0x42521230
    v_bfe_u32 v9, s44, v90, 3
    s_mov_b32 s44, 0x15415433
    v_bfe_u32 v10, s44, v90, 3
    v_sub_u32 v10, v10, v9
    v_lshlrev_b32 v9, 8, v9
    v_lshl_add_u32 v9, v89, 5, v9
    v_add_u32 v9, 149248, v9
K2_ROUND:
    v_and_b32 v94, 63, v0
    v_lshlrev_b32 v89, 4, v0
    v_add_u32 v90, 101376, v89
    v_mov_b32 v12, 0
    v_mov_b32 v13, 0
    v_mov_b32 v14, 0
    v_mov_b32 v15, 0
    ds_write_b128 v90, v[12:15]
    v_cmp_gt_u32 vcc, 400, v0
    v_add_u32 v90, 142336, v89
    v_mov_b32 v93, 0xffff0000
    v_cndmask_b32 v109, 0, -1, vcc
    v_cmp_eq_u32 vcc, 416, v0
    v_mov_b32 v110, v109
    v_mov_b32 v111, v109
    v_cndmask_b32 v108, v109, 12, vcc
    v_cmp_gt_u32 vcc, 417, v0
    s_and_saveexec_b64 s[52:53], vcc
    s_cbranch_execz K2_INIT1
    ds_write_b128 v90, v[108:111]
K2_INIT1:
    s_mov_b64 exec, -1
    s_cmp_eq_u32 s63, 0
    s_cbranch_scc1 K2_LATER
    s_cmp_eq_u32 s18, 11
    s_cbranch_scc1 K2_NOPUB
    s_cmp_lg_u32 s18, 10
    s_cbranch_scc1 K2_DRAIN
    v_mov_b32 v90, 156416
    v_mov_b32 v57, s62
    s_mov_b32 s45, 0x40000
    s_cmp_lg_u32 s2, 255
    s_cbranch_scc1 POLLGA
    s_mov_b32 s44, 0xad0000
    s_movk_i32 s47, 0
    v_lshlrev_b32 v56, 4, v94
POLLA:
    buffer_load_dwordx4 v[58:61], v56, s[8:11], s44 offen sc1
    s_waitcnt vmcnt(0)
    v_xor_b32 v58, v57, v58
    v_xor_b32 v59, v57, v59
    v_xor_b32 v60, v57, v60
    v_xor_b32 v61, v57, v61
    v_or3_b32 v58, v58, v59, v60
    v_or_b32 v58, v58, v61
    v_cmp_ne_u32 vcc, 0, v58
    s_cbranch_vccz POLLWA
    s_sub_u32 s45, s45, 1
    s_cbranch_scc0 POLLA
POLLWA:
    v_lshlrev_b32 v56, 8, v94
    s_mov_b64 exec, 0xffff
    buffer_store_dword v57, v56, s[8:11], s44 offen offset:1024 sc1
    s_mov_b64 exec, -1
    s_branch POLLEDA
POLLGA:
    s_and_b32 s44, s2, 15
    s_lshl_b32 s44, s44, 8
    s_add_u32 s44, s44, 0xad0400
    v_mov_b32 v56, 0
    s_mov_b64 exec, 1
POLLHA:
    buffer_load_dwordx2 v[58:59], v56, s[8:11], s44 offen sc1
    s_waitcnt vmcnt(0)
    v_cmp_ne_u32 vcc, v57, v58
    s_cbranch_vccz POLLXA
    s_sub_u32 s45, s45, 1
    s_cbranch_scc1 POLLXA
    s_sleep 1
    s_branch POLLHA
POLLXA:
    s_mov_b64 exec, -1
POLLEDA:
    s_lshl_b32 s44, s21, 2
    s_add_u32 s44, s44, 0xa80000
    v_lshlrev_b32 v89, 12, v94
    buffer_load_dword v40, v89, s[8:11], s44 offen offset:0 sc1
    buffer_load_dword v41, v89, s[8:11], s44 offen offset:1024 sc1
    buffer_load_dword v42, v89, s[8:11], s44 offen offset:2048 sc1
    buffer_load_dword v43, v89, s[8:11], s44 offen offset:3072 sc1
    v_lshlrev_b32 v89, 4, v94
    v_add_u32 v89, 155392, v89
    s_waitcnt vmcnt(0)
    ds_write_b128 v89, v[40:43]
    s_branch K2_NOPUB
K2_DRAIN:
    s_load_dwordx4 s[36:39], s[0:1], 48
    s_lshl_b32 s46, s18, 12
    v_lshlrev_b32 v92, 4, v94
    v_add_u32 v44, s46, v92
    s_waitcnt lgkmcnt(0)
    s_cmp_ge_u32 s18, 4
    s_cselect_b32 s36, s38, s36
    s_cselect_b32 s37, s39, s37
    s_cselect_b32 s47, 0x4000, 0
    v_subrev_u32 v92, s47, v44
    s_cmp_ge_u32 s2, 250
    s_cbranch_scc1 K2_WST
    v_mov_b32 v89, 156416
    v_lshlrev_b32 v91, 4, v0
    s_mul_i32 s45, s2, 40960
K2_GO:
    buffer_store_dwordx4 v[64:67], v91, s[8:11], s45 offen sc1
    s_add_u32 s45, s45, 10240
    buffer_store_dwordx4 v[68:71], v91, s[8:11], s45 offen sc1
    s_add_u32 s45, s45, 10240
    buffer_store_dwordx4 v[72:75], v91, s[8:11], s45 offen sc1
    s_add_u32 s45, s45, 10240
    buffer_store_dwordx4 v[76:79], v91, s[8:11], s45 offen sc1
K2_WST:
    s_cmp_eq_u32 s63, 0
    s_cbranch_scc1 K2_DRE
    s_mov_b32 s63, 0
    s_cmp_ge_u32 s18, 10
    s_cbranch_scc1 K2_DRE
    v_mov_b32 v89, 156416
    s_waitcnt vmcnt(0)
    s_mov_b64 exec, 1
    ds_add_rtn_u32 v90, v89, v8
    s_mov_b64 exec, -1
    s_waitcnt lgkmcnt(0)
    v_readfirstlane_b32 s44, v90
    s_cmp_lg_u32 s44, 9
    s_cbranch_scc1 K2_DRE
    s_lshl_b32 s45, s2, 2
    s_add_u32 s45, s45, 0xad4000
    v_mov_b32 v89, 0
    v_mov_b32 v90, s62
    s_mov_b64 exec, 1
    buffer_store_dword v90, v89, s[8:11], s45 offen sc1
    s_mov_b64 exec, -1
K2_DRE:
    global_load_dwordx4 v[16:19], v92, s[36:37] offset:0
    global_load_dwordx4 v[20:23], v92, s[36:37] offset:1024
    global_load_dwordx4 v[24:27], v92, s[36:37] offset:2048
    global_load_dwordx4 v[28:31], v92, s[36:37] offset:3072
    s_waitcnt vmcnt(0)
    ds_write_b128 v44, v[16:19] offset:57344
    ds_write_b128 v44, v[20:23] offset:58368
    ds_write_b128 v44, v[24:27] offset:59392
    ds_write_b128 v44, v[28:31] offset:60416
K2_NOPUB:
    s_mov_b32 s63, 0
    s_waitcnt lgkmcnt(0)
    s_barrier
    s_cmp_lg_u32 s18, 11
    s_cbranch_scc1 K2_SYNCED
    v_mov_b32 v57, s62
    s_mov_b32 s45, 0x40000
    s_cmp_lg_u32 s2, 255
    s_cbranch_scc1 POLLGB
    s_mov_b32 s44, 0xad4000
    s_movk_i32 s47, 0
    v_lshlrev_b32 v56, 4, v94
POLLB:
    buffer_load_dwordx4 v[58:61], v56, s[8:11], s44 offen sc1
    s_waitcnt vmcnt(0)
    v_xor_b32 v58, v57, v58
    v_xor_b32 v59, v57, v59
    v_xor_b32 v60, v57, v60
    v_xor_b32 v61, v57, v61
    v_or3_b32 v58, v58, v59, v60
    v_or_b32 v58, v58, v61
    v_cmp_ne_u32 vcc, 0, v58
    s_cbranch_vccz POLLWB
    s_sub_u32 s45, s45, 1
    s_cbranch_scc0 POLLB
POLLWB:
    v_lshlrev_b32 v56, 8, v94
    s_mov_b64 exec, 0xffff
    buffer_store_dword v57, v56, s[8:11], s44 offen offset:1024 sc1
    s_mov_b64 exec, -1
    s_branch POLLEDB
POLLGB:
    s_and_b32 s44, s2, 15
    s_lshl_b32 s44, s44, 8
    s_add_u32 s44, s44, 0xad4400
    v_mov_b32 v56, 0
    s_mov_b64 exec, 1
POLLHB:
    buffer_load_dwordx2 v[58:59], v56, s[8:11], s44 offen sc1
    s_waitcnt vmcnt(0)
    v_cmp_ne_u32 vcc, v57, v58
    s_cbranch_vccz POLLXB
    s_sub_u32 s45, s45, 1
    s_cbranch_scc1 POLLXB
    s_sleep 1
    s_branch POLLHB
POLLXB:
    s_mov_b64 exec, -1
POLLEDB:
    v_mov_b32 v89, 156416
    ds_write_b32 v89, v8 offset:8
    s_cmp_lg_u32 s2, 0
    s_cbranch_scc1 K2_SYNCED
    v_mov_b32 v89, 0xae0000
    s_mov_b64 exec, 1
    buffer_store_dword v57, v89, s[8:11], 0 offen sc1
    s_mov_b64 exec, -1
    s_branch K2_SYNCED
K2_LATER:
    s_waitcnt lgkmcnt(0)
    s_barrier
K2_SYNCED:
    v_lshlrev_b32 v89, 4, v94
    v_add_u32 v89, 155392, v89
    ds_read_b128 v[40:43], v89
    s_waitcnt lgkmcnt(0)
K2_TABOK:
    v_lshrrev_b32 v48, 16, v40
    v_lshrrev_b32 v49, 16, v41
    v_lshrrev_b32 v50, 16, v42
    v_lshrrev_b32 v51, 16, v43
    v_add_u32 v46, v48, v49
    v_add_u32 v47, v46, v50
    v_add_u32 v89, v47, v51
    v_mov_b32 v44, v89
    v_mul_u32_u24 v90, 10240, v94
    s_nop 0
    v_add_u32_dpp v44, v44, v44 row_shr:1 row_mask:0xf bank_mask:0xf
    v_and_b32 v52, 0xffff, v40
    v_add_u32 v52, v52, v90
    v_add_u32_dpp v44, v44, v44 row_shr:2 row_mask:0xf bank_mask:0xf
    v_and_b32 v53, 0xffff, v41
    v_add3_u32 v53, v53, v90, s57
    v_add_u32_dpp v44, v44, v44 row_shr:4 row_mask:0xf bank_mask:0xf
    v_and_b32 v54, 0xffff, v42
    v_add3_u32 v54, v54, v90, s58
    v_add_u32_dpp v44, v44, v44 row_shr:8 row_mask:0xf bank_mask:0xf
    v_and_b32 v55, 0xffff, v43
    v_add3_u32 v55, v55, v90, s59
    v_add_u32_dpp v44, v44, v44 row_bcast:15 row_mask:0xa bank_mask:0xf
    s_lshl_b32 s44, s18, 8
    s_add_u32 s44, s44, s19
    v_add_u32_dpp v44, v44, v44 row_bcast:31 row_mask:0xc bank_mask:0xf
    s_add_u32 s45, s19, s43
    s_lshl_b32 s46, s18, 10
    v_readlane_b32 s20, v44, 63
    v_sub_u32 v44, v44, v89
    s_add_u32 s46, s46, 101376
    s_cmp_gt_u32 s20, s45
    s_cselect_b32 s22, 1, 0
    s_min_u32 s45, s45, s20
    s_sub_i32 s45, s45, s44
    v_sub_u32 v88, s45, v94
    s_cmp_le_i32 s45, 0
    s_cbranch_scc1 K2_NOKEY
    v_add_u32 v45, v44, v48
    v_add_u32 v46, v44, v46
    v_add_u32 v47, v44, v47
    v_sub_u32 v52, v52, v44
    v_subrev_u32 v44, s44, v44
    v_add_u32 v48, v48, v44
    v_max_i32 v91, 0, v44
    v_lshl_add_u32 v91, v91, 2, s46
    v_cmpx_lt_i32 vcc, 0, v48
    v_cmpx_gt_i32 vcc, 256, v44
    ds_max_u32 v91, v52
    s_mov_b64 exec, -1
    v_sub_u32 v53, v53, v45
    v_subrev_u32 v45, s44, v45
    v_add_u32 v49, v49, v45
    v_max_i32 v91, 0, v45
    v_lshl_add_u32 v91, v91, 2, s46
    v_cmpx_lt_i32 vcc, 0, v49
    v_cmpx_gt_i32 vcc, 256, v45
    ds_max_u32 v91, v53
    s_mov_b64 exec, -1
    v_sub_u32 v54, v54, v46
    v_subrev_u32 v46, s44, v46
    v_add_u32 v50, v50, v46
    v_max_i32 v91, 0, v46
    v_lshl_add_u32 v91, v91, 2, s46
    v_cmpx_lt_i32 vcc, 0, v50
    v_cmpx_gt_i32 vcc, 256, v46
    ds_max_u32 v91, v54
    s_mov_b64 exec, -1
    v_sub_u32 v55, v55, v47
    v_subrev_u32 v47, s44, v47
    v_add_u32 v51, v51, v47
    v_max_i32 v91, 0, v47
    v_lshl_add_u32 v91, v91, 2, s46
    v_cmpx_lt_i32 vcc, 0, v51
    v_cmpx_gt_i32 vcc, 256, v47
    ds_max_u32 v91, v55
    s_mov_b64 exec, -1
    v_lshl_add_u32 v91, v94, 2, s46
    ds_read2st64_b32 v[56:57], v91 offset0:0 offset1:1
    ds_read2st64_b32 v[58:59], v91 offset0:2 offset1:3
    v_add_u32 v92, s44, v94
    v_mov_b32 v91, 0x8000000
    s_waitcnt lgkmcnt(0)
    v_max_u32_dpp v56, v56, v56 row_shr:1 row_mask:0xf bank_mask:0xf
    v_max_u32_dpp v57, v57, v57 row_shr:1 row_mask:0xf bank_mask:0xf
    v_max_u32_dpp v58, v58, v58 row_shr:1 row_mask:0xf bank_mask:0xf
    v_max_u32_dpp v59, v59, v59 row_shr:1 row_mask:0xf bank_mask:0xf
    v_max_u32_dpp v56, v56, v56 row_shr:2 row_mask:0xf bank_mask:0xf
    v_max_u32_dpp v57, v57, v57 row_shr:2 row_mask:0xf bank_mask:0xf
    v_max_u32_dpp v58, v58, v58 row_shr:2 row_mask:0xf bank_mask:0xf
    v_max_u32_dpp v59, v59, v59 row_shr:2 row_mask:0xf bank_mask:0xf
    v_max_u32_dpp v56, v56, v56 row_shr:4 row_mask:0xf bank_mask:0xf
    v_max_u32_dpp v57, v57, v57 row_shr:4 row_mask:0xf bank_mask:0xf
    v_max_u32_dpp v58, v58, v58 row_shr:4 row_mask:0xf bank_mask:0xf
    v_max_u32_dpp v59, v59, v59 row_shr:4 row_mask:0xf bank_mask:0xf
    v_max_u32_dpp v56, v56, v56 row_shr:8 row_mask:0xf bank_mask:0xf
    v_max_u32_dpp v57, v57, v57 row_shr:8 row_mask:0xf bank_mask:0xf
    v_max_u32_dpp v58, v58, v58 row_shr:8 row_mask:0xf bank_mask:0xf
    v_max_u32_dpp v59, v59, v59 row_shr:8 row_mask:0xf bank_mask:0xf
    v_max_u32_dpp v56, v56, v56 row_bcast:15 row_mask:0xa bank_mask:0xf
    v_max_u32_dpp v57, v57, v57 row_bcast:15 row_mask:0xa bank_mask:0xf
    v_max_u32_dpp v58, v58, v58 row_bcast:15 row_mask:0xa bank_mask:0xf
    v_max_u32_dpp v59, v59, v59 row_bcast:15 row_mask:0xa bank_mask:0xf
    v_max_u32_dpp v56, v56, v56 row_bcast:31 row_mask:0xc bank_mask:0xf
    v_max_u32_dpp v57, v57, v57 row_bcast:31 row_mask:0xc bank_mask:0xf
    v_max_u32_dpp v58, v58, v58 row_bcast:31 row_mask:0xc bank_mask:0xf
    v_max_u32_dpp v59, v59, v59 row_bcast:31 row_mask:0xc bank_mask:0xf
    v_readlane_b32 s44, v56, 63
    v_readlane_b32 s45, v57, 63
    v_readlane_b32 s46, v58, 63
    v_add_u32 v56, v56, v92
    s_max_u32 s45, s45, s44
    s_max_u32 s46, s46, s45
    v_max_u32 v57, s44, v57
    v_max_u32 v58, s45, v58
    v_max_u32 v59, s46, v59
    v_add_u32 v57, v57, v92
    v_add_u32 v58, v58, v92
    v_add_u32 v59, v59, v92
    v_cmpx_ge_i32 vcc, 0, v88
    v_mov_b32 v56, v91
    s_mov_b64 exec, -1
    buffer_load_ubyte v80, v56, s[8:11], s48 offen offset:0 sc1
    v_cmpx_ge_i32 vcc, 64, v88
    v_mov_b32 v57, v91
    s_mov_b64 exec, -1
    buffer_load_ubyte v81, v57, s[8:11], s48 offen offset:64 sc1
    v_cmpx_ge_i32 vcc, 128, v88
    v_mov_b32 v58, v91
    s_mov_b64 exec, -1
    buffer_load_ubyte v82, v58, s[8:11], s48 offen offset:128 sc1
    v_cmpx_ge_i32 vcc, 192, v88
    v_mov_b32 v59, v91
    s_mov_b64 exec, -1
    buffer_load_ubyte v83, v59, s[8:11], s48 offen offset:192 sc1
    v_lshlrev_b32 v60, 4, v56
    v_lshlrev_b32 v61, 4, v57
    v_lshlrev_b32 v62, 4, v58
    v_lshlrev_b32 v63, 4, v59
    v_mov_b32 v90, 156416
    ds_read_b32 v91, v90 offset:8
    s_waitcnt lgkmcnt(0)
    v_readfirstlane_b32 s47, v91
    s_cmp_eq_u32 s47, 0
    s_cbranch_scc1 K2_NOTYET
    buffer_load_dwordx4 v[64:67], v60, s[8:11], 0 offen offset:0 sc1
    buffer_load_dwordx4 v[68:71], v61, s[8:11], 0 offen offset:1024 sc1
    buffer_load_dwordx4 v[72:75], v62, s[8:11], 0 offen offset:2048 sc1
    buffer_load_dwordx4 v[76:79], v63, s[8:11], 0 offen offset:3072 sc1
    s_waitcnt vmcnt(4)
    s_branch K2_LDDONE
K2_NOTYET:
    s_waitcnt vmcnt(0)
K2_LDDONE:
    v_mov_b32 v92, 148736
    v_cmpx_lt_i32 vcc, 0, v88
    s_cbranch_execz K2_RKDONE
    v_lshlrev_b32 v80, 2, v80
    v_add_u32 v91, v92, v80
    ds_add_rtn_u32 v84, v91, v8
    v_cmpx_lt_i32 vcc, 64, v88
    s_cbranch_execz K2_RKDONE
    v_lshlrev_b32 v81, 2, v81
    v_add_u32 v91, v92, v81
    ds_add_rtn_u32 v85, v91, v8
    v_cmpx_lt_i32 vcc, 128, v88
    s_cbranch_execz K2_RKDONE
    v_lshlrev_b32 v82, 2, v82
    v_add_u32 v91, v92, v82
    ds_add_rtn_u32 v86, v91, v8
    v_cmpx_lt_i32 vcc, 192, v88
    s_cbranch_execz K2_RKDONE
    v_lshlrev_b32 v83, 2, v83
    v_add_u32 v91, v92, v83
    ds_add_rtn_u32 v87, v91, v8
K2_RKDONE:
    s_mov_b64 exec, -1
    s_cmp_lg_u32 s47, 0
    s_cbranch_scc1 K2_KEYED
K2_RSPIN:
    s_sleep 1
    ds_read_b32 v91, v90 offset:8
    s_waitcnt lgkmcnt(0)
    v_readfirstlane_b32 s47, v91
    s_cmp_eq_u32 s47, 0
    s_cbranch_scc1 K2_RSPIN
    buffer_load_dwordx4 v[64:67], v60, s[8:11], 0 offen offset:0 sc1
    buffer_load_dwordx4 v[68:71], v61, s[8:11], 0 offen offset:1024 sc1
    buffer_load_dwordx4 v[72:75], v62, s[8:11], 0 offen offset:2048 sc1
    buffer_load_dwordx4 v[76:79], v63, s[8:11], 0 offen offset:3072 sc1
    s_branch K2_KEYED
K2_NOKEY:
K2_KEYED:
    s_cmp_lg_u32 s19, 0
    s_cbranch_scc1 K2_NOWT
    v_and_b32 v89, 0x198, v2
    v_lshl_add_u32 v89, v1, 6, v89
    s_lshl_b32 s44, s61, 5
    s_add_u32 s44, s44, 57344
    v_add_u32 v89, s44, v89
    ds_read_b64_tr_b16 v[128:129], v89 offset:0
    ds_read_b64_tr_b16 v[130:131], v89 offset:512
    ds_read_b64_tr_b16 v[132:133], v89 offset:4096
    ds_read_b64_tr_b16 v[134:135], v89 offset:4608
    ds_read_b64_tr_b16 v[136:137], v89 offset:8192
    ds_read_b64_tr_b16 v[138:139], v89 offset:8704
    ds_read_b64_tr_b16 v[140:141], v89 offset:12288
    ds_read_b64_tr_b16 v[142:143], v89 offset:12800
    ds_read_b64_tr_b16 v[144:145], v89 offset:16384
    ds_read_b64_tr_b16 v[146:147], v89 offset:16896
    s_waitcnt lgkmcnt(4)
    ds_read_b64_tr_b16 v[148:149], v89 offset:20480
    ds_read_b64_tr_b16 v[150:151], v89 offset:20992
    ds_read_b64_tr_b16 v[152:153], v89 offset:24576
    ds_read_b64_tr_b16 v[154:155], v89 offset:25088
    ds_read_b64_tr_b16 v[156:157], v89 offset:28672
    ds_read_b64_tr_b16 v[158:159], v89 offset:29184
    ds_read_b64_tr_b16 v[160:161], v89 offset:32768
    ds_read_b64_tr_b16 v[162:163], v89 offset:33280
    ds_read_b64_tr_b16 v[164:165], v89 offset:36864
    ds_read_b64_tr_b16 v[166:167], v89 offset:37376
K2_NOWT:
    v_lshlrev_b32 v89, 2, v94
    v_add_u32 v89, 148736, v89
    v_cmp_gt_u32 vcc, s54, v94
    s_waitcnt lgkmcnt(0)
    s_barrier
    ds_read_b32 v5, v89
    s_waitcnt lgkmcnt(0)
    v_add_u32 v89, 8, v5
    v_and_b32 v89, -8, v89
    v_max_u32 v89, 32, v89
    v_cndmask_b32 v89, 0, v89, vcc
    v_mov_b32 v4, v89
    s_nop 1
    v_add_u32_dpp v4, v4, v4 row_shr:1 row_mask:0xf bank_mask:0xf
    s_nop 1
    v_add_u32_dpp v4, v4, v4 row_shr:2 row_mask:0xf bank_mask:0xf
    s_nop 1
    v_add_u32_dpp v4, v4, v4 row_shr:4 row_mask:0xf bank_mask:0xf
    s_nop 1
    v_add_u32_dpp v4, v4, v4 row_shr:8 row_mask:0xf bank_mask:0xf
    s_nop 1
    v_add_u32_dpp v4, v4, v4 row_bcast:15 row_mask:0xa bank_mask:0xf
    s_nop 1
    v_add_u32_dpp v4, v4, v4 row_bcast:31 row_mask:0xc bank_mask:0xf
    s_nop 0
    v_readlane_b32 s44, v4, 63
    v_sub_u32 v4, v4, v89
    s_cmp_le_u32 s44, 3168
    s_cbranch_scc1 K2_FITS
    s_movk_i32 s43, 1792
    s_waitcnt vmcnt(0)
    s_barrier
    s_branch K2_ROUND
K2_FITS:
    ds_bpermute_b32 v80, v80, v4
    ds_bpermute_b32 v81, v81, v4
    ds_bpermute_b32 v82, v82, v4
    ds_bpermute_b32 v83, v83, v4
    s_mov_b32 s23, s18
    s_mov_b32 s39, 1
    s_mov_b32 s35, 64
    s_mov_b32 s34, 1
    v_and_b32 v49, 15, v0
    v_lshlrev_b32 v49, 4, v49
    v_mov_b32 v51, v49
    v_mov_b32 v53, v49
    v_mov_b32 v55, v49
    v_mov_b32 v57, v49
    v_mov_b32 v59, v49
    v_mov_b32 v61, v49
    v_mov_b32 v63, v49
    v_mov_b32 v20, 0
    v_mov_b32 v21, 0
    v_mov_b32 v22, 0
    v_mov_b32 v23, 0
    v_mov_b32 v28, 0
    v_mov_b32 v29, 0
    v_mov_b32 v30, 0
    v_mov_b32 v31, 0
    v_mov_b32 v36, 0
    v_mov_b32 v37, 0
    v_mov_b32 v38, 0
    v_mov_b32 v39, 0
    v_mov_b32 v44, 0
    v_mov_b32 v45, 0
    v_mov_b32 v46, 0
    v_mov_b32 v47, 0
    s_cmp_ge_u32 s23, s54
    s_cselect_b32 s25, 256, 0
    s_cselect_b32 s44, s54, 0
    s_sub_u32 s24, s23, s44
    v_readlane_b32 s45, v4, s24
    v_readlane_b32 s27, v5, s24
    s_lshl_b32 s44, s24, 10
    s_add_u32 s44, s44, 101376
    s_lshl_b32 s40, s45, 5
    s_add_u32 s41, s45, s27
    s_lshl_b32 s41, s41, 5
    s_lshl_b32 s42, s45, 1
    s_add_u32 s42, s42, 142336
    s_cmp_eq_u32 s25, 0
    s_cselect_b32 s36, s44, s40
    s_xor_b32 s25, s25, s3
    s_mov_b32 s26, 1
    s_mov_b32 s47, 142336
    s_waitcnt lgkmcnt(0)
    v_cmpx_lt_i32 vcc, 0, v88
    s_cbranch_execz K2_WRDONE
    v_add_u32 v80, v80, v84
    v_lshl_add_u32 v84, v80, 1, s47
    v_lshlrev_b32 v80, 5, v80
    s_waitcnt vmcnt(3)
    ds_write_b16 v84, v66
    v_cmpx_lt_i32 vcc, 64, v88
    s_cbranch_execz K2_WRDONE
    v_add_u32 v81, v81, v85
    v_lshl_add_u32 v85, v81, 1, s47
    v_lshlrev_b32 v81, 5, v81
    s_waitcnt vmcnt(2)
    ds_write_b16 v85, v70
    v_cmpx_lt_i32 vcc, 128, v88
    s_cbranch_execz K2_WRDONE
    v_add_u32 v82, v82, v86
    v_lshl_add_u32 v86, v82, 1, s47
    v_lshlrev_b32 v82, 5, v82
    s_waitcnt vmcnt(1)
    ds_write_b16 v86, v74
    v_cmpx_lt_i32 vcc, 192, v88
    s_cbranch_execz K2_WRDONE
    v_add_u32 v83, v83, v87
    v_lshl_add_u32 v87, v83, 1, s47
    v_lshlrev_b32 v83, 5, v83
    s_waitcnt vmcnt(0)
    ds_write_b16 v87, v78
K2_WRDONE:
    s_mov_b64 exec, -1
    s_waitcnt vmcnt(0) lgkmcnt(0)
    s_barrier
    v_add_u32 v62, s42, v3
    ds_read_u16 v48, v62 offset:0
    ds_read_u16 v50, v62 offset:8
    ds_read_u16 v52, v62 offset:16
    ds_read_u16 v54, v62 offset:24
    ds_read_u16 v56, v62 offset:32
    ds_read_u16 v58, v62 offset:40
    ds_read_u16 v60, v62 offset:48
    ds_read_u16 v62, v62 offset:56
    s_waitcnt lgkmcnt(0)
    s_cmp_le_i32 s27, 0
    s_cbranch_scc1 K2_PISSUED
    buffer_load_dwordx4 v[16:19], v[48:49], s[4:7], s25 idxen offen
    s_cmp_le_i32 s27, 4
    s_cbranch_scc1 K2_PISSUED
    buffer_load_dwordx4 v[20:23], v[50:51], s[4:7], s25 idxen offen
    s_cmp_le_i32 s27, 8
    s_cbranch_scc1 K2_PISSUED
    buffer_load_dwordx4 v[24:27], v[52:53], s[4:7], s25 idxen offen
    s_cmp_le_i32 s27, 12
    s_cbranch_scc1 K2_PISSUED
    buffer_load_dwordx4 v[28:31], v[54:55], s[4:7], s25 idxen offen
K2_PISSUED:
    s_cmp_lg_u32 s18, 11
    s_cbranch_scc1 K2_NOZR
    v_add_lshl_u32 v89, v4, v5, 5
    ds_write_b128 v89, v[12:15]
    ds_write_b128 v89, v[12:15] offset:16
K2_NOZR:
    v_cmpx_lt_i32 vcc, 0, v88
    s_cbranch_execz K2_EXDONE
    v_lshlrev_b32 v108, 16, v64
    v_and_b32 v109, v93, v64
    v_lshlrev_b32 v110, 16, v65
    v_and_b32 v111, v93, v65
    v_and_b32 v112, v93, v66
    v_lshlrev_b32 v113, 16, v67
    v_and_b32 v114, v93, v67
    v_mul_f32 v116, v108, v112
    v_mul_f32 v117, v109, v112
    v_mul_f32 v118, v110, v112
    v_mul_f32 v119, v111, v112
    v_cvt_pk_bf16_f32 v66, v116, v117
    v_cvt_pk_bf16_f32 v67, v118, v119
    ds_write_b128 v80, v[64:67]
    v_mul_f32 v116, v108, v113
    v_mul_f32 v117, v109, v113
    v_mul_f32 v118, v110, v113
    v_mul_f32 v119, v111, v113
    v_cvt_pk_bf16_f32 v120, v116, v117
    v_cvt_pk_bf16_f32 v121, v118, v119
    v_mul_f32 v116, v108, v114
    v_mul_f32 v117, v109, v114
    v_mul_f32 v118, v110, v114
    v_mul_f32 v119, v111, v114
    v_cvt_pk_bf16_f32 v122, v116, v117
    v_cvt_pk_bf16_f32 v123, v118, v119
    ds_write_b128 v80, v[120:123] offset:16
    v_cmpx_lt_i32 vcc, 64, v88
    s_cbranch_execz K2_EXDONE
    v_lshlrev_b32 v108, 16, v68
    v_and_b32 v109, v93, v68
    v_lshlrev_b32 v110, 16, v69
    v_and_b32 v111, v93, v69
    v_and_b32 v112, v93, v70
    v_lshlrev_b32 v113, 16, v71
    v_and_b32 v114, v93, v71
    v_mul_f32 v116, v108, v112
    v_mul_f32 v117, v109, v112
    v_mul_f32 v118, v110, v112
    v_mul_f32 v119, v111, v112
    v_cvt_pk_bf16_f32 v70, v116, v117
    v_cvt_pk_bf16_f32 v71, v118, v119
    ds_write_b128 v81, v[68:71]
    v_mul_f32 v116, v108, v113
    v_mul_f32 v117, v109, v113
    v_mul_f32 v118, v110, v113
    v_mul_f32 v119, v111, v113
    v_cvt_pk_bf16_f32 v124, v116, v117
    v_cvt_pk_bf16_f32 v125, v118, v119
    v_mul_f32 v116, v108, v114
    v_mul_f32 v117, v109, v114
    v_mul_f32 v118, v110, v114
    v_mul_f32 v119, v111, v114
    v_cvt_pk_bf16_f32 v126, v116, v117
    v_cvt_pk_bf16_f32 v127, v118, v119
    ds_write_b128 v81, v[124:127] offset:16
    v_cmpx_lt_i32 vcc, 128, v88
    s_cbranch_execz K2_EXDONE
    v_lshlrev_b32 v108, 16, v72
    v_and_b32 v109, v93, v72
    v_lshlrev_b32 v110, 16, v73
    v_and_b32 v111, v93, v73
    v_and_b32 v112, v93, v74
    v_lshlrev_b32 v113, 16, v75
    v_and_b32 v114, v93, v75
    v_mul_f32 v116, v108, v112
    v_mul_f32 v117, v109, v112
    v_mul_f32 v118, v110, v112
    v_mul_f32 v119, v111, v112
    v_cvt_pk_bf16_f32 v74, v116, v117
    v_cvt_pk_bf16_f32 v75, v118, v119
    ds_write_b128 v82, v[72:75]
    v_mul_f32 v116, v108, v113
    v_mul_f32 v117, v109, v113
    v_mul_f32 v118, v110, v113
    v_mul_f32 v119, v111, v113
    v_cvt_pk_bf16_f32 v120, v116, v117
    v_cvt_pk_bf16_f32 v121, v118, v119
    v_mul_f32 v116, v108, v114
    v_mul_f32 v117, v109, v114
    v_mul_f32 v118, v110, v114
    v_mul_f32 v119, v111, v114
    v_cvt_pk_bf16_f32 v122, v116, v117
    v_cvt_pk_bf16_f32 v123, v118, v119
    ds_write_b128 v82, v[120:123] offset:16
    v_cmpx_lt_i32 vcc, 192, v88
    s_cbranch_execz K2_EXDONE
    v_lshlrev_b32 v108, 16, v76
    v_and_b32 v109, v93, v76
    v_lshlrev_b32 v110, 16, v77
    v_and_b32 v111, v93, v77
    v_and_b32 v112, v93, v78
    v_lshlrev_b32 v113, 16, v79
    v_and_b32 v114, v93, v79
    v_mul_f32 v116, v108, v112
    v_mul_f32 v117, v109, v112
    v_mul_f32 v118, v110, v112
    v_mul_f32 v119, v111, v112
    v_cvt_pk_bf16_f32 v78, v116, v117
    v_cvt_pk_bf16_f32 v79, v118, v119
    ds_write_b128 v83, v[76:79]
    v_mul_f32 v116, v108, v113
    v_mul_f32 v117, v109, v113
    v_mul_f32 v118, v110, v113
    v_mul_f32 v119, v111, v113
    v_cvt_pk_bf16_f32 v124, v116, v117
    v_cvt_pk_bf16_f32 v125, v118, v119
    v_mul_f32 v116, v108, v114
    v_mul_f32 v117, v109, v114
    v_mul_f32 v118, v110, v114
    v_mul_f32 v119, v111, v114
    v_cvt_pk_bf16_f32 v126, v116, v117
    v_cvt_pk_bf16_f32 v127, v118, v119
    ds_write_b128 v83, v[124:127] offset:16
K2_EXDONE:
    s_mov_b64 exec, -1
    s_waitcnt lgkmcnt(0)
    s_barrier
    s_cmp_le_i32 s27, 16
    s_cbranch_scc1 K2_ISSUED
    buffer_load_dwordx4 v[32:35], v[56:57], s[4:7], s25 idxen offen
    s_cmp_le_i32 s27, 20
    s_cbranch_scc1 K2_ISSUED
    buffer_load_dwordx4 v[36:39], v[58:59], s[4:7], s25 idxen offen
    s_cmp_le_i32 s27, 24
    s_cbranch_scc1 K2_ISSUED
    buffer_load_dwordx4 v[40:43], v[60:61], s[4:7], s25 idxen offen
    s_cmp_le_i32 s27, 28
    s_cbranch_scc1 K2_ISSUED
    buffer_load_dwordx4 v[44:47], v[62:63], s[4:7], s25 idxen offen
    s_branch K2_ISSUED
K2_TOP:
    s_cmp_le_i32 s35, 28
    s_cbranch_scc1 K2_OLD
    s_cmp_eq_u32 s39, 0
    s_cbranch_scc1 K2_OLD
    s_waitcnt vmcnt(6)
.p2align 3
    v_perm_b32 v64, v20, v16, s50
    v_perm_b32 v68, v20, v16, s51
    v_perm_b32 v72, v21, v17, s50
    v_perm_b32 v76, v21, v17, s51
    v_perm_b32 v80, v22, v18, s50
    v_perm_b32 v84, v22, v18, s51
    v_perm_b32 v88, v23, v19, s50
    v_perm_b32 v92, v23, v19, s51
    s_waitcnt lgkmcnt(0)
    s_cmp_le_i32 s27, 0
    s_cbranch_scc1 K2_X0
    buffer_load_dwordx4 v[16:19], v[48:49], s[4:7], s25 idxen offen
    s_cmp_le_i32 s27, 4
    s_cbranch_scc1 K2_X1
    buffer_load_dwordx4 v[20:23], v[50:51], s[4:7], s25 idxen offen
    s_waitcnt vmcnt(6)
.p2align 3
    v_perm_b32 v65, v28, v24, s50
    v_perm_b32 v69, v28, v24, s51
    v_perm_b32 v73, v29, v25, s50
    v_perm_b32 v77, v29, v25, s51
    v_perm_b32 v81, v30, v26, s50
    v_perm_b32 v85, v30, v26, s51
    v_perm_b32 v89, v31, v27, s50
    v_perm_b32 v93, v31, v27, s51
    s_cmp_le_i32 s27, 8
    s_cbranch_scc1 K2_X2
    buffer_load_dwordx4 v[24:27], v[52:53], s[4:7], s25 idxen offen
    s_cmp_le_i32 s27, 12
    s_cbranch_scc1 K2_X3
    buffer_load_dwordx4 v[28:31], v[54:55], s[4:7], s25 idxen offen
    s_waitcnt vmcnt(6)
.p2align 3
    v_perm_b32 v66, v36, v32, s50
    v_perm_b32 v70, v36, v32, s51
    v_perm_b32 v74, v37, v33, s50
    v_perm_b32 v78, v37, v33, s51
    v_perm_b32 v82, v38, v34, s50
    v_perm_b32 v86, v38, v34, s51
    v_perm_b32 v90, v39, v35, s50
    v_perm_b32 v94, v39, v35, s51
    s_cmp_le_i32 s27, 16
    s_cbranch_scc1 K2_X4
    buffer_load_dwordx4 v[32:35], v[56:57], s[4:7], s25 idxen offen
    s_cmp_le_i32 s27, 20
    s_cbranch_scc1 K2_X5
    buffer_load_dwordx4 v[36:39], v[58:59], s[4:7], s25 idxen offen
    s_waitcnt vmcnt(6)
.p2align 3
    v_perm_b32 v67, v44, v40, s50
    v_perm_b32 v71, v44, v40, s51
    v_perm_b32 v75, v45, v41, s50
    v_perm_b32 v79, v45, v41, s51
    v_perm_b32 v83, v46, v42, s50
    v_perm_b32 v87, v46, v42, s51
    v_perm_b32 v91, v47, v43, s50
    v_perm_b32 v95, v47, v43, s51
    s_cmp_le_i32 s27, 24
    s_cbranch_scc1 K2_X6
    buffer_load_dwordx4 v[40:43], v[60:61], s[4:7], s25 idxen offen
    s_cmp_le_i32 s27, 28
    s_cbranch_scc1 K2_X7
    buffer_load_dwordx4 v[44:47], v[62:63], s[4:7], s25 idxen offen
K2_ISSUED:
    s_mov_b64 s[28:29], s[24:25]
    s_mov_b64 s[30:31], s[26:27]
    s_mov_b32 s37, s36
    s_cmp_gt_i32 s27, 32
    s_cbranch_scc1 K2_NOCLAIM
    s_mov_b64 exec, 1
    ds_add_rtn_u32 v6, v11, v8
    s_mov_b64 exec, -1
K2_NOCLAIM:
    s_cmp_eq_u32 s34, 0
    s_cbranch_scc1 K2_MFACC
.p2align 3
    v_mfma_f32_16x16x32_bf16 v[96:99], v[12:15], v[64:67], 0
    v_mfma_f32_16x16x32_bf16 v[100:103], v[12:15], v[68:71], 0
    v_mfma_f32_16x16x32_bf16 v[104:107], v[12:15], v[72:75], 0
    v_mfma_f32_16x16x32_bf16 v[108:111], v[12:15], v[76:79], 0
    v_mfma_f32_16x16x32_bf16 v[112:115], v[12:15], v[80:83], 0
    v_mfma_f32_16x16x32_bf16 v[116:119], v[12:15], v[84:87], 0
    v_mfma_f32_16x16x32_bf16 v[120:123], v[12:15], v[88:91], 0
    v_mfma_f32_16x16x32_bf16 v[124:127], v[12:15], v[92:95], 0
    s_branch K2_MFDONE
.p2align 3
K2_MFACC:
    v_mfma_f32_16x16x32_bf16 v[96:99], v[12:15], v[64:67], v[96:99]
    v_mfma_f32_16x16x32_bf16 v[100:103], v[12:15], v[68:71], v[100:103]
    v_mfma_f32_16x16x32_bf16 v[104:107], v[12:15], v[72:75], v[104:107]
    v_mfma_f32_16x16x32_bf16 v[108:111], v[12:15], v[76:79], v[108:111]
    v_mfma_f32_16x16x32_bf16 v[112:115], v[12:15], v[80:83], v[112:115]
    v_mfma_f32_16x16x32_bf16 v[116:119], v[12:15], v[84:87], v[116:119]
    v_mfma_f32_16x16x32_bf16 v[120:123], v[12:15], v[88:91], v[120:123]
    v_mfma_f32_16x16x32_bf16 v[124:127], v[12:15], v[92:95], v[124:127]
K2_MFDONE:
    s_waitcnt lgkmcnt(0)
    s_cmp_gt_i32 s35, 32
    s_cbranch_scc1 K2_NOER
    v_mad_i32_i24 v52, v10, s33, v9
    ds_read_b32 v54, v11 offset:8
    ds_read_b32 v56, v11 offset:12
    ds_read_b128 v[64:67], v52 offset:0
    ds_read_b128 v[68:71], v52 offset:16
    ds_read_b128 v[72:75], v52 offset:1536
    ds_read_b128 v[76:79], v52 offset:1552
    ds_read_b128 v[80:83], v52 offset:3072
    ds_read_b128 v[84:87], v52 offset:3088
    ds_read_b128 v[88:91], v52 offset:4608
    ds_read_b128 v[92:95], v52 offset:4624
K2_NOER:
    v_add_u32 v48, s40, v2
    v_add_u32 v50, 0x200, v48
    v_min_u32 v48, s41, v48
    v_min_u32 v50, s41, v50
    ds_read_b64_tr_b16 v[12:13], v48
    ds_read_b64_tr_b16 v[14:15], v50
    s_cmp_gt_i32 s27, 32
    s_cbranch_scc0 K2_NEWITEM
    s_sub_i32 s27, s27, 32
    s_add_u32 s40, s40, 1024
    s_add_u32 s42, s42, 64
    s_mov_b32 s26, 0
K2_HAVE:
    s_cmp_gt_i32 s35, 32
    s_cbranch_scc1 K2_NOEPI
    s_and_b32 s44, s32, 15
    s_lshl_b32 s44, s44, 4
    v_xor_b32 v58, s44, v49
    v_add3_u32 v58, v58, v7, s38
    s_waitcnt lgkmcnt(2)
    v_mul_f32 v96, v96, v64
    v_mul_f32 v100, v100, v65
    v_mul_f32 v104, v104, v66
    v_mul_f32 v108, v108, v67
    v_mul_f32 v112, v112, v68
    v_mul_f32 v116, v116, v69
    v_mul_f32 v120, v120, v70
    v_mul_f32 v124, v124, v71
    v_fmac_f32 v96, v97, v72
    v_fmac_f32 v100, v101, v73
    v_fmac_f32 v104, v105, v74
    v_fmac_f32 v108, v109, v75
    v_fmac_f32 v112, v113, v76
    v_fmac_f32 v116, v117, v77
    v_fmac_f32 v120, v121, v78
    v_fmac_f32 v124, v125, v79
    v_fmac_f32 v96, v98, v80
    v_fmac_f32 v100, v102, v81
    v_fmac_f32 v104, v106, v82
    v_fmac_f32 v108, v110, v83
    v_fmac_f32 v112, v114, v84
    v_fmac_f32 v116, v118, v85
    v_fmac_f32 v120, v122, v86
    v_fmac_f32 v124, v126, v87
    v_fmac_f32 v96, v99, v88
    v_fmac_f32 v100, v103, v89
    v_fmac_f32 v104, v107, v90
    v_fmac_f32 v108, v111, v91
    v_fmac_f32 v112, v115, v92
    v_fmac_f32 v116, v119, v93
    v_fmac_f32 v120, v123, v94
    v_fmac_f32 v124, v127, v95
    v_cvt_pk_bf16_f32 v64, v96, v100
    v_cvt_pk_bf16_f32 v65, v104, v108
    v_cvt_pk_bf16_f32 v66, v112, v116
    v_cvt_pk_bf16_f32 v67, v120, v124
    s_cmp_eq_u32 s33, s3
    s_cbranch_scc1 K2_EH0
    s_mov_b32 s45, 0x100000
K2_EH1:
    v_readfirstlane_b32 s46, v54
    v_readfirstlane_b32 s47, v56
    s_bitcmp1_b64 s[46:47], s32
    s_cbranch_scc1 K2_EW1
    s_sub_u32 s45, s45, 1
    s_cbranch_scc1 K2_EW1
    s_sleep 1
    ds_read_b32 v54, v11 offset:8
    ds_read_b32 v56, v11 offset:12
    s_waitcnt lgkmcnt(0)
    s_branch K2_EH1
K2_EH0:
    s_lshl_b64 s[46:47], 1, s32
    ds_write_b128 v58, v[64:67]
    v_mov_b32 v68, s46
    v_mov_b32 v69, s47
    s_mov_b64 exec, 1
    ds_or_b64 v11, v[68:69] offset:8
    s_mov_b64 exec, -1
    s_branch K2_EDONE
K2_EW1:
    ds_write_b128 v58, v[64:67]
K2_EDONE:
K2_NOEPI:
    v_add_u32 v62, s42, v3
    ds_read_u16 v48, v62 offset:0
    ds_read_u16 v50, v62 offset:8
    ds_read_u16 v52, v62 offset:16
    ds_read_u16 v54, v62 offset:24
    ds_read_u16 v56, v62 offset:32
    ds_read_u16 v58, v62 offset:40
    ds_read_u16 v60, v62 offset:48
    ds_read_u16 v62, v62 offset:56
    s_mov_b64 s[32:33], s[28:29]
    s_mov_b64 s[34:35], s[30:31]
    s_mov_b32 s38, s37
    s_branch K2_TOP
K2_NEWITEM:
    v_readfirstlane_b32 s23, v6
    s_cmp_lt_u32 s23, s55
    s_cselect_b32 s39, 1, 0
    s_cbranch_scc0 K2_HAVE
    s_cmp_ge_u32 s23, s54
    s_cselect_b32 s25, 256, 0
    s_cselect_b32 s44, s54, 0
    s_sub_u32 s24, s23, s44
    v_readlane_b32 s45, v4, s24
    v_readlane_b32 s27, v5, s24
    s_lshl_b32 s44, s24, 10
    s_add_u32 s44, s44, 101376
    s_lshl_b32 s40, s45, 5
    s_add_u32 s41, s45, s27
    s_lshl_b32 s41, s41, 5
    s_lshl_b32 s42, s45, 1
    s_add_u32 s42, s42, 142336
    s_cmp_eq_u32 s25, 0
    s_cselect_b32 s36, s44, s40
    s_xor_b32 s25, s25, s3
    s_mov_b32 s26, 1
    s_branch K2_HAVE
K2_X0:
    s_waitcnt vmcnt(0)
    s_branch K2_C1
K2_X1:
    v_mov_b32 v20, 0
    v_mov_b32 v21, 0
    v_mov_b32 v22, 0
    v_mov_b32 v23, 0
    s_waitcnt vmcnt(1)
    s_branch K2_C1
K2_X2:
    s_waitcnt vmcnt(2)
    s_branch K2_C2
K2_X3:
    v_mov_b32 v28, 0
    v_mov_b32 v29, 0
    v_mov_b32 v30, 0
    v_mov_b32 v31, 0
    s_waitcnt vmcnt(3)
    s_branch K2_C2
K2_X4:
    s_waitcnt vmcnt(4)
    s_branch K2_C3
K2_X5:
    v_mov_b32 v36, 0
    v_mov_b32 v37, 0
    v_mov_b32 v38, 0
    v_mov_b32 v39, 0
    s_waitcnt vmcnt(5)
    s_branch K2_C3
K2_X6:
    s_branch K2_ISSUED
K2_X7:
    v_mov_b32 v44, 0
    v_mov_b32 v45, 0
    v_mov_b32 v46, 0
    v_mov_b32 v47, 0
    s_branch K2_ISSUED
.p2align 3
K2_C1:
    v_perm_b32 v65, v28, v24, s50
    v_perm_b32 v69, v28, v24, s51
    v_perm_b32 v73, v29, v25, s50
    v_perm_b32 v77, v29, v25, s51
    v_perm_b32 v81, v30, v26, s50
    v_perm_b32 v85, v30, v26, s51
    v_perm_b32 v89, v31, v27, s50
    v_perm_b32 v93, v31, v27, s51
K2_C2:
    v_perm_b32 v66, v36, v32, s50
    v_perm_b32 v70, v36, v32, s51
    v_perm_b32 v74, v37, v33, s50
    v_perm_b32 v78, v37, v33, s51
    v_perm_b32 v82, v38, v34, s50
    v_perm_b32 v86, v38, v34, s51
    v_perm_b32 v90, v39, v35, s50
    v_perm_b32 v94, v39, v35, s51
K2_C3:
    v_perm_b32 v67, v44, v40, s50
    v_perm_b32 v71, v44, v40, s51
    v_perm_b32 v75, v45, v41, s50
    v_perm_b32 v79, v45, v41, s51
    v_perm_b32 v83, v46, v42, s50
    v_perm_b32 v87, v46, v42, s51
    v_perm_b32 v91, v47, v43, s50
    v_perm_b32 v95, v47, v43, s51
    s_branch K2_ISSUED
K2_OLD:
    s_waitcnt vmcnt(0) lgkmcnt(0)
    s_cmp_le_i32 s35, 0
    s_cbranch_scc1 K2_PZ0
.p2align 3
    v_perm_b32 v64, v20, v16, s50
    v_perm_b32 v68, v20, v16, s51
    v_perm_b32 v72, v21, v17, s50
    v_perm_b32 v76, v21, v17, s51
    v_perm_b32 v80, v22, v18, s50
    v_perm_b32 v84, v22, v18, s51
    v_perm_b32 v88, v23, v19, s50
    v_perm_b32 v92, v23, v19, s51
    s_cmp_le_i32 s35, 8
    s_cbranch_scc1 K2_PZ1
.p2align 3
    v_perm_b32 v65, v28, v24, s50
    v_perm_b32 v69, v28, v24, s51
    v_perm_b32 v73, v29, v25, s50
    v_perm_b32 v77, v29, v25, s51
    v_perm_b32 v81, v30, v26, s50
    v_perm_b32 v85, v30, v26, s51
    v_perm_b32 v89, v31, v27, s50
    v_perm_b32 v93, v31, v27, s51
    s_cmp_le_i32 s35, 16
    s_cbranch_scc1 K2_PZ2
.p2align 3
    v_perm_b32 v66, v36, v32, s50
    v_perm_b32 v70, v36, v32, s51
    v_perm_b32 v74, v37, v33, s50
    v_perm_b32 v78, v37, v33, s51
    v_perm_b32 v82, v38, v34, s50
    v_perm_b32 v86, v38, v34, s51
    v_perm_b32 v90, v39, v35, s50
    v_perm_b32 v94, v39, v35, s51
    s_cmp_le_i32 s35, 24
    s_cbranch_scc1 K2_PZ3
.p2align 3
    v_perm_b32 v67, v44, v40, s50
    v_perm_b32 v71, v44, v40, s51
    v_perm_b32 v75, v45, v41, s50
    v_perm_b32 v79, v45, v41, s51
    v_perm_b32 v83, v46, v42, s50
    v_perm_b32 v87, v46, v42, s51
    v_perm_b32 v91, v47, v43, s50
    v_perm_b32 v95, v47, v43, s51
K2_ISSUE:
    s_cmp_eq_u32 s39, 0
    s_cbranch_scc1 K2_TAIL
    s_cmp_le_i32 s27, 0
    s_cbranch_scc1 K2_ISSUED
    buffer_load_dwordx4 v[16:19], v[48:49], s[4:7], s25 idxen offen
    s_cmp_le_i32 s27, 4
    s_cbranch_scc1 K2_Z1
    buffer_load_dwordx4 v[20:23], v[50:51], s[4:7], s25 idxen offen
    s_cmp_le_i32 s27, 8
    s_cbranch_scc1 K2_ISSUED
    buffer_load_dwordx4 v[24:27], v[52:53], s[4:7], s25 idxen offen
    s_cmp_le_i32 s27, 12
    s_cbranch_scc1 K2_Z3
    buffer_load_dwordx4 v[28:31], v[54:55], s[4:7], s25 idxen offen
    s_cmp_le_i32 s27, 16
    s_cbranch_scc1 K2_ISSUED
    buffer_load_dwordx4 v[32:35], v[56:57], s[4:7], s25 idxen offen
    s_cmp_le_i32 s27, 20
    s_cbranch_scc1 K2_Z5
    buffer_load_dwordx4 v[36:39], v[58:59], s[4:7], s25 idxen offen
    s_cmp_le_i32 s27, 24
    s_cbranch_scc1 K2_ISSUED
    buffer_load_dwordx4 v[40:43], v[60:61], s[4:7], s25 idxen offen
    s_cmp_le_i32 s27, 28
    s_cbranch_scc1 K2_Z7
    buffer_load_dwordx4 v[44:47], v[62:63], s[4:7], s25 idxen offen
    s_branch K2_ISSUED
K2_Z1:
    v_mov_b32 v20, 0
    v_mov_b32 v21, 0
    v_mov_b32 v22, 0
    v_mov_b32 v23, 0
    s_branch K2_ISSUED
K2_Z3:
    v_mov_b32 v28, 0
    v_mov_b32 v29, 0
    v_mov_b32 v30, 0
    v_mov_b32 v31, 0
    s_branch K2_ISSUED
K2_Z5:
    v_mov_b32 v36, 0
    v_mov_b32 v37, 0
    v_mov_b32 v38, 0
    v_mov_b32 v39, 0
    s_branch K2_ISSUED
K2_Z7:
    v_mov_b32 v44, 0
    v_mov_b32 v45, 0
    v_mov_b32 v46, 0
    v_mov_b32 v47, 0
    s_branch K2_ISSUED
K2_PZ0:
    v_mov_b32 v64, 0
    v_mov_b32 v68, 0
    v_mov_b32 v72, 0
    v_mov_b32 v76, 0
    v_mov_b32 v80, 0
    v_mov_b32 v84, 0
    v_mov_b32 v88, 0
    v_mov_b32 v92, 0
K2_PZ1:
    v_mov_b32 v65, 0
    v_mov_b32 v69, 0
    v_mov_b32 v73, 0
    v_mov_b32 v77, 0
    v_mov_b32 v81, 0
    v_mov_b32 v85, 0
    v_mov_b32 v89, 0
    v_mov_b32 v93, 0
K2_PZ2:
    v_mov_b32 v66, 0
    v_mov_b32 v70, 0
    v_mov_b32 v74, 0
    v_mov_b32 v78, 0
    v_mov_b32 v82, 0
    v_mov_b32 v86, 0
    v_mov_b32 v90, 0
    v_mov_b32 v94, 0
K2_PZ3:
    v_mov_b32 v67, 0
    v_mov_b32 v71, 0
    v_mov_b32 v75, 0
    v_mov_b32 v79, 0
    v_mov_b32 v83, 0
    v_mov_b32 v87, 0
    v_mov_b32 v91, 0
    v_mov_b32 v95, 0
    s_branch K2_ISSUE
K2_TAIL:
    s_cmp_lg_u32 s19, 0
    s_cbranch_scc1 K2_OALD
    v_mov_b32 v16, 0
    v_mov_b32 v17, 0
    v_mov_b32 v18, 0
    v_mov_b32 v19, 0
    v_mov_b32 v20, 0
    v_mov_b32 v21, 0
    v_mov_b32 v22, 0
    v_mov_b32 v23, 0
    v_mov_b32 v24, 0
    v_mov_b32 v25, 0
    v_mov_b32 v26, 0
    v_mov_b32 v27, 0
    v_mov_b32 v28, 0
    v_mov_b32 v29, 0
    v_mov_b32 v30, 0
    v_mov_b32 v31, 0
    s_branch K2_OAOK
K2_OALD:
    v_lshlrev_b32 v48, 4, v0
    s_mul_i32 s44, s2, 49152
    s_add_u32 s44, s44, 0x1000000
    buffer_load_dwordx4 v[16:19], v48, s[8:11], s44 offen sc1
    s_add_u32 s44, s44, 12288
    buffer_load_dwordx4 v[20:23], v48, s[8:11], s44 offen sc1
    s_add_u32 s44, s44, 12288
    buffer_load_dwordx4 v[24:27], v48, s[8:11], s44 offen sc1
    s_add_u32 s44, s44, 12288
    buffer_load_dwordx4 v[28:31], v48, s[8:11], s44 offen sc1
    s_add_u32 s44, s44, 12288
K2_OAOK:
    s_cmp_eq_u32 s34, 0
    s_cbranch_scc1 K2_MFACCT
.p2align 3
    v_mfma_f32_16x16x32_bf16 v[96:99], v[12:15], v[64:67], 0
    v_mfma_f32_16x16x32_bf16 v[100:103], v[12:15], v[68:71], 0
    v_mfma_f32_16x16x32_bf16 v[104:107], v[12:15], v[72:75], 0
    v_mfma_f32_16x16x32_bf16 v[108:111], v[12:15], v[76:79], 0
    v_mfma_f32_16x16x32_bf16 v[112:115], v[12:15], v[80:83], 0
    v_mfma_f32_16x16x32_bf16 v[116:119], v[12:15], v[84:87], 0
    v_mfma_f32_16x16x32_bf16 v[120:123], v[12:15], v[88:91], 0
    v_mfma_f32_16x16x32_bf16 v[124:127], v[12:15], v[92:95], 0
    s_branch K2_MFDONET
.p2align 3
K2_MFACCT:
    v_mfma_f32_16x16x32_bf16 v[96:99], v[12:15], v[64:67], v[96:99]
    v_mfma_f32_16x16x32_bf16 v[100:103], v[12:15], v[68:71], v[100:103]
    v_mfma_f32_16x16x32_bf16 v[104:107], v[12:15], v[72:75], v[104:107]
    v_mfma_f32_16x16x32_bf16 v[108:111], v[12:15], v[76:79], v[108:111]
    v_mfma_f32_16x16x32_bf16 v[112:115], v[12:15], v[80:83], v[112:115]
    v_mfma_f32_16x16x32_bf16 v[116:119], v[12:15], v[84:87], v[116:119]
    v_mfma_f32_16x16x32_bf16 v[120:123], v[12:15], v[88:91], v[120:123]
    v_mfma_f32_16x16x32_bf16 v[124:127], v[12:15], v[92:95], v[124:127]
K2_MFDONET:
    v_mad_i32_i24 v52, v10, s33, v9
    ds_read_b32 v54, v11 offset:8
    ds_read_b32 v56, v11 offset:12
    ds_read_b128 v[64:67], v52 offset:0
    ds_read_b128 v[68:71], v52 offset:16
    ds_read_b128 v[72:75], v52 offset:1536
    ds_read_b128 v[76:79], v52 offset:1552
    ds_read_b128 v[80:83], v52 offset:3072
    ds_read_b128 v[84:87], v52 offset:3088
    ds_read_b128 v[88:91], v52 offset:4608
    ds_read_b128 v[92:95], v52 offset:4624
    s_mul_i32 s44, s60, 8448
    s_lshl_b32 s45, s61, 5
    s_add_u32 s44, s44, s45
    s_add_u32 s44, s44, 142336
    v_mul_u32_u24 v43, 33, v49
    v_lshrrev_b32 v40, 1, v1
    v_add3_u32 v43, v43, v40, s44
    v_lshrrev_b32 v40, 5, v0
    v_and_b32 v41, 31, v0
    v_mul_u32_u24 v44, 528, v40
    v_lshl_add_u32 v44, v41, 4, v44
    v_add_u32 v44, 142336, v44
    v_lshlrev_b32 v45, 4, v0
    v_add_u32 v46, 12288, v45
    s_and_b32 s44, s32, 15
    s_lshl_b32 s44, s44, 4
    v_xor_b32 v58, s44, v49
    v_add3_u32 v58, v58, v7, s38
    s_waitcnt lgkmcnt(0)
    v_mul_f32 v96, v96, v64
    v_mul_f32 v100, v100, v65
    v_mul_f32 v104, v104, v66
    v_mul_f32 v108, v108, v67
    v_mul_f32 v112, v112, v68
    v_mul_f32 v116, v116, v69
    v_mul_f32 v120, v120, v70
    v_mul_f32 v124, v124, v71
    v_fmac_f32 v96, v97, v72
    v_fmac_f32 v100, v101, v73
    v_fmac_f32 v104, v105, v74
    v_fmac_f32 v108, v109, v75
    v_fmac_f32 v112, v113, v76
    v_fmac_f32 v116, v117, v77
    v_fmac_f32 v120, v121, v78
    v_fmac_f32 v124, v125, v79
    v_fmac_f32 v96, v98, v80
    v_fmac_f32 v100, v102, v81
    v_fmac_f32 v104, v106, v82
    v_fmac_f32 v108, v110, v83
    v_fmac_f32 v112, v114, v84
    v_fmac_f32 v116, v118, v85
    v_fmac_f32 v120, v122, v86
    v_fmac_f32 v124, v126, v87
    v_fmac_f32 v96, v99, v88
    v_fmac_f32 v100, v103, v89
    v_fmac_f32 v104, v107, v90
    v_fmac_f32 v108, v111, v91
    v_fmac_f32 v112, v115, v92
    v_fmac_f32 v116, v119, v93
    v_fmac_f32 v120, v123, v94
    v_fmac_f32 v124, v127, v95
    v_cvt_pk_bf16_f32 v64, v96, v100
    v_cvt_pk_bf16_f32 v65, v104, v108
    v_cvt_pk_bf16_f32 v66, v112, v116
    v_cvt_pk_bf16_f32 v67, v120, v124
    s_cmp_eq_u32 s33, s3
    s_cbranch_scc1 K2_EH0T
    s_mov_b32 s45, 0x100000
K2_EH1T:
    v_readfirstlane_b32 s46, v54
    v_readfirstlane_b32 s47, v56
    s_bitcmp1_b64 s[46:47], s32
    s_cbranch_scc1 K2_EW1T
    s_sub_u32 s45, s45, 1
    s_cbranch_scc1 K2_EW1T
    s_sleep 1
    ds_read_b32 v54, v11 offset:8
    ds_read_b32 v56, v11 offset:12
    s_waitcnt lgkmcnt(0)
    s_branch K2_EH1T
K2_EH0T:
    s_lshl_b64 s[46:47], 1, s32
    ds_write_b128 v58, v[64:67]
    v_mov_b32 v68, s46
    v_mov_b32 v69, s47
    s_mov_b64 exec, 1
    ds_or_b64 v11, v[68:69] offset:8
    s_mov_b64 exec, -1
    s_branch K2_EDONET
K2_EW1T:
    ds_write_b128 v58, v[64:67]
K2_EDONET:
    ds_read_b64 v[40:41], v11 offset:8
    s_lshl_b32 s44, s60, 6
    v_lshrrev_b32 v12, 2, v49
    v_add_u32 v12, s44, v12
    ds_bpermute_b32 v14, v12, v4
    v_xor_b32 v13, v1, v49
    v_lshlrev_b32 v12, 8, v12
    v_add_u32 v12, 101376, v12
    s_waitcnt lgkmcnt(0)
    v_lshlrev_b32 v14, 5, v14
    v_readfirstlane_b32 s46, v40
    v_readfirstlane_b32 s47, v41
    s_cmp_eq_u32 s3, 0
    s_cbranch_scc1 K2_NOSWAP
    v_swap_b32 v12, v14
K2_NOSWAP:
    v_xor_b32 v36, 0, v13
    v_add_u32 v32, v36, v12
    v_add_u32 v36, v36, v14
    v_xor_b32 v37, 64, v13
    v_add_u32 v33, v37, v12
    v_add_u32 v37, v37, v14
    v_xor_b32 v38, 128, v13
    v_add_u32 v34, v38, v12
    v_add_u32 v38, v38, v14
    v_xor_b32 v39, 192, v13
    v_add_u32 v35, v39, v12
    v_add_u32 v39, v39, v14
    s_bcnt1_i32_b64 s45, s[46:47]
    s_mov_b32 s40, s3
    s_mov_b32 s41, 0
    s_mov_b32 s42, 0
    s_cmp_eq_u32 s45, s54
    s_cbranch_scc1 K2_S2RUN
    s_barrier
    s_mov_b32 s42, 1
K2_S2RUN:
    s_cmp_lg_u32 s40, 0
    s_cbranch_scc1 K2_S2H1
    ds_read_b128 v[64:67], v32 offset:0
    ds_read_b128 v[68:71], v33 offset:0
    ds_read_b128 v[72:75], v34 offset:256
    ds_read_b128 v[76:79], v35 offset:256
    ds_read_b128 v[80:83], v34 offset:0
    ds_read_b128 v[84:87], v35 offset:0
    ds_read_b128 v[88:91], v32 offset:256
    ds_read_b128 v[92:95], v33 offset:256
    ds_read_b128 v[96:99], v32 offset:512
    ds_read_b128 v[100:103], v33 offset:512
    ds_read_b128 v[104:107], v34 offset:768
    ds_read_b128 v[108:111], v35 offset:768
    ds_read_b128 v[112:115], v34 offset:512
    ds_read_b128 v[116:119], v35 offset:512
    ds_read_b128 v[120:123], v32 offset:768
    s_waitcnt lgkmcnt(14)
    ds_read_b128 v[124:127], v33 offset:768
    s_waitcnt vmcnt(0)
    s_waitcnt lgkmcnt(15)
    v_mfma_f32_16x16x32_bf16 v[16:19], v[128:131], v[64:67], v[16:19]
    s_waitcnt lgkmcnt(14)
    v_mfma_f32_16x16x32_bf16 v[16:19], v[132:135], v[68:71], v[16:19]
    s_waitcnt lgkmcnt(13)
    v_mfma_f32_16x16x32_bf16 v[16:19], v[136:139], v[72:75], v[16:19]
    s_waitcnt lgkmcnt(12)
    v_mfma_f32_16x16x32_bf16 v[16:19], v[140:143], v[76:79], v[16:19]
    s_waitcnt lgkmcnt(11)
    v_mfma_f32_16x16x32_bf16 v[20:23], v[152:155], v[80:83], v[20:23]
    s_waitcnt lgkmcnt(10)
    v_mfma_f32_16x16x32_bf16 v[20:23], v[156:159], v[84:87], v[20:23]
    s_waitcnt lgkmcnt(9)
    v_mfma_f32_16x16x32_bf16 v[20:23], v[144:147], v[88:91], v[20:23]
    s_waitcnt lgkmcnt(8)
    v_mfma_f32_16x16x32_bf16 v[20:23], v[148:151], v[92:95], v[20:23]
    s_waitcnt lgkmcnt(7)
    v_mfma_f32_16x16x32_bf16 v[24:27], v[144:147], v[96:99], v[24:27]
    s_waitcnt lgkmcnt(6)
    v_mfma_f32_16x16x32_bf16 v[24:27], v[148:151], v[100:103], v[24:27]
    s_waitcnt lgkmcnt(5)
    v_mfma_f32_16x16x32_bf16 v[24:27], v[160:163], v[104:107], v[24:27]
    s_waitcnt lgkmcnt(4)
    v_mfma_f32_16x16x32_bf16 v[24:27], v[164:167], v[108:111], v[24:27]
    s_waitcnt lgkmcnt(3)
    v_mfma_f32_16x16x32_bf16 v[28:31], v[160:163], v[112:115], v[28:31]
    s_waitcnt lgkmcnt(2)
    v_mfma_f32_16x16x32_bf16 v[28:31], v[164:167], v[116:119], v[28:31]
    s_waitcnt lgkmcnt(1)
    v_mfma_f32_16x16x32_bf16 v[28:31], v[144:147], v[120:123], v[28:31]
    s_waitcnt lgkmcnt(0)
    v_mfma_f32_16x16x32_bf16 v[28:31], v[148:151], v[124:127], v[28:31]
    s_branch K2_S2AFT
K2_S2H1:
    ds_read_b128 v[64:67], v36 offset:512
    ds_read_b128 v[68:71], v37 offset:512
    ds_read_b128 v[72:75], v38 offset:768
    ds_read_b128 v[76:79], v39 offset:768
    ds_read_b128 v[80:83], v38 offset:512
    ds_read_b128 v[84:87], v39 offset:512
    ds_read_b128 v[88:91], v36 offset:768
    ds_read_b128 v[92:95], v37 offset:768
    ds_read_b128 v[96:99], v36 offset:0
    ds_read_b128 v[100:103], v37 offset:0
    ds_read_b128 v[104:107], v38 offset:256
    ds_read_b128 v[108:111], v39 offset:256
    ds_read_b128 v[112:115], v38 offset:0
    ds_read_b128 v[116:119], v39 offset:0
    ds_read_b128 v[120:123], v36 offset:256
    s_waitcnt lgkmcnt(14)
    ds_read_b128 v[124:127], v37 offset:256
    s_waitcnt vmcnt(0)
    s_waitcnt lgkmcnt(15)
    v_mfma_f32_16x16x32_bf16 v[16:19], v[136:139], v[64:67], v[16:19]
    s_waitcnt lgkmcnt(14)
    v_mfma_f32_16x16x32_bf16 v[16:19], v[140:143], v[68:71], v[16:19]
    s_waitcnt lgkmcnt(13)
    v_mfma_f32_16x16x32_bf16 v[16:19], v[136:139], v[72:75], v[16:19]
    s_waitcnt lgkmcnt(12)
    v_mfma_f32_16x16x32_bf16 v[16:19], v[140:143], v[76:79], v[16:19]
    s_waitcnt lgkmcnt(11)
    v_mfma_f32_16x16x32_bf16 v[20:23], v[160:163], v[80:83], v[20:23]
    s_waitcnt lgkmcnt(10)
    v_mfma_f32_16x16x32_bf16 v[20:23], v[164:167], v[84:87], v[20:23]
    s_waitcnt lgkmcnt(9)
    v_mfma_f32_16x16x32_bf16 v[20:23], v[160:163], v[88:91], v[20:23]
    s_waitcnt lgkmcnt(8)
    v_mfma_f32_16x16x32_bf16 v[20:23], v[164:167], v[92:95], v[20:23]
    s_waitcnt lgkmcnt(7)
    v_mfma_f32_16x16x32_bf16 v[24:27], v[152:155], v[96:99], v[24:27]
    s_waitcnt lgkmcnt(6)
    v_mfma_f32_16x16x32_bf16 v[24:27], v[156:159], v[100:103], v[24:27]
    s_waitcnt lgkmcnt(5)
    v_mfma_f32_16x16x32_bf16 v[24:27], v[160:163], v[104:107], v[24:27]
    s_waitcnt lgkmcnt(4)
    v_mfma_f32_16x16x32_bf16 v[24:27], v[164:167], v[108:111], v[24:27]
    s_waitcnt lgkmcnt(3)
    v_mfma_f32_16x16x32_bf16 v[28:31], v[152:155], v[112:115], v[28:31]
    s_waitcnt lgkmcnt(2)
    v_mfma_f32_16x16x32_bf16 v[28:31], v[156:159], v[116:119], v[28:31]
    s_waitcnt lgkmcnt(1)
    v_mfma_f32_16x16x32_bf16 v[28:31], v[160:163], v[120:123], v[28:31]
    s_waitcnt lgkmcnt(0)
    v_mfma_f32_16x16x32_bf16 v[28:31], v[164:167], v[124:127], v[28:31]
K2_S2AFT:
    s_cmp_lg_u32 s41, 0
    s_cbranch_scc1 K2_S2END
    s_mov_b32 s41, 1
    s_xor_b32 s40, s40, 256
    s_cmp_lg_u32 s42, 0
    s_cbranch_scc1 K2_S2RUN
    s_barrier
    s_branch K2_S2RUN
K2_S2END:
    s_cmp_eq_u32 s22, 0
    s_cbranch_scc1 K2_FINAL
    s_add_u32 s19, s19, s43
    v_lshlrev_b32 v48, 4, v0
    s_mul_i32 s44, s2, 49152
    s_add_u32 s44, s44, 0x1000000
    s_nop 7
    buffer_store_dwordx4 v[16:19], v48, s[8:11], s44 offen sc1
    s_add_u32 s44, s44, 12288
    buffer_store_dwordx4 v[20:23], v48, s[8:11], s44 offen sc1
    s_add_u32 s44, s44, 12288
    buffer_store_dwordx4 v[24:27], v48, s[8:11], s44 offen sc1
    s_add_u32 s44, s44, 12288
    buffer_store_dwordx4 v[28:31], v48, s[8:11], s44 offen sc1
    s_add_u32 s44, s44, 12288
    s_waitcnt vmcnt(0)
    s_barrier
    s_branch K2_ROUND
K2_FINAL:
    s_mov_b32 s44, 0xbfb8aa3b
    v_mul_f32 v64, s44, v16
    v_mul_f32 v65, s44, v17
    v_mul_f32 v66, s44, v18
    v_mul_f32 v67, s44, v19
    v_exp_f32 v64, v64
    v_exp_f32 v65, v65
    v_exp_f32 v66, v66
    v_exp_f32 v67, v67
    v_add_f32 v64, 1.0, v64
    v_add_f32 v65, 1.0, v65
    v_add_f32 v66, 1.0, v66
    v_add_f32 v67, 1.0, v67
    v_rcp_f32 v64, v64
    v_rcp_f32 v65, v65
    v_rcp_f32 v66, v66
    v_rcp_f32 v67, v67
    v_cvt_pk_bf16_f32 v72, v16, v17
    v_cvt_pk_bf16_f32 v73, v18, v19
    v_mul_f32 v20, v20, v64
    v_mul_f32 v21, v21, v65
    v_mul_f32 v22, v22, v66
    v_mul_f32 v23, v23, v67
    v_cvt_pk_bf16_f32 v74, v20, v21
    v_cvt_pk_bf16_f32 v75, v22, v23
    v_mul_f32 v24, v24, v64
    v_mul_f32 v25, v25, v65
    v_mul_f32 v26, v26, v66
    v_mul_f32 v27, v27, v67
    v_cvt_pk_bf16_f32 v76, v24, v25
    v_cvt_pk_bf16_f32 v77, v26, v27
    v_mul_f32 v28, v28, v64
    v_mul_f32 v29, v29, v65
    v_mul_f32 v30, v30, v66
    v_mul_f32 v31, v31, v67
    v_cvt_pk_bf16_f32 v78, v28, v29
    v_cvt_pk_bf16_f32 v79, v30, v31
    ds_write_b64 v43, v[72:73] offset:0
    ds_write_b64 v43, v[74:75] offset:128
    ds_write_b64 v43, v[76:77] offset:256
    ds_write_b64 v43, v[78:79] offset:384
    s_lshl_b32 s44, s56, 9
    s_add_u32 s12, s12, s44
    s_addc_u32 s13, s13, 0
    s_lshl_b32 s14, s54, 9
    s_waitcnt lgkmcnt(0)
    s_barrier
    ds_read_b128 v[64:67], v44
    s_cmp_ge_u32 s18, 8
    s_cbranch_scc1 K2_ST1
    ds_read_b128 v[68:71], v44 offset:12672
    s_waitcnt lgkmcnt(0)
    buffer_store_dwordx4 v[68:71], v46, s[12:15], 0 offen nt
K2_ST1:
    s_waitcnt lgkmcnt(0)
    buffer_store_dwordx4 v[64:67], v45, s[12:15], 0 offen nt
K2_END:
    s_endpgm
CODE_END:
.section .rodata,"a"
.p2align 6
.amdhsa_kernel standalone__tensor_product_equiv_equiformer__graph_kernel
  .amdhsa_next_free_vgpr 168
  .amdhsa_next_free_sgpr 64
  .amdhsa_accum_offset 168
  .amdhsa_group_segment_fixed_size 0
  .amdhsa_kernarg_size 96
  .amdhsa_user_sgpr_count 2
  .amdhsa_user_sgpr_kernarg_segment_ptr 1
  .amdhsa_system_sgpr_workgroup_id_x 1
  .amdhsa_float_denorm_mode_32 3
.end_amdhsa_kernel
```
